```python
import torch

def _softmax(x, axis=-1):
    return torch.softmax(x, dim=axis)
def _gelu(x):
    return torch.nn.functional.gelu(x, approximate="tanh")
def _silu(x):
    return torch.nn.functional.silu(x)
def _sigmoid(x):
    return torch.sigmoid(x)
def _layernorm(x, axis=-1, eps=1e-5):
    m = x.mean(dim=axis, keepdim=True)
    v = x.var(dim=axis, keepdim=True, unbiased=False)
    return (x - m) / torch.sqrt(v + eps)
def _scatter_add(tgt, idx, src, axis=0):
    return tgt.clone().index_add_(axis, idx, src)
def _segment_sum(src, seg, n):
    out = torch.zeros((n,) + src.shape[1:], dtype=src.dtype)
    return out.index_add_(0, seg, src)
def _pad(x, pw):
    flat = tuple(v for pair in reversed(pw) for v in pair)
    return torch.nn.functional.pad(x, flat)

kernel_name = 'standalone__glu_gated_geglu__decode'

def setup_inputs():

    _w = (lambda a: (lambda t: t.to(torch.bfloat16) if t.is_floating_point() else t)(torch.as_tensor(a)))
    B, S, Dm, Df = 1, 1, 1024, 3584
    return {
        "x": _w((lambda *s: torch.randn(*s, dtype=torch.bfloat16) * 0.05)(B, S, Dm)),
        "w_gate": _w((lambda *s: torch.randn(*s, dtype=torch.bfloat16) * 0.05)(Dm, Df) * (Dm ** -0.5)),
        "w_up": _w((lambda *s: torch.randn(*s, dtype=torch.bfloat16) * 0.05)(Dm, Df) * (Dm ** -0.5)),
        "w_down": _w((lambda *s: torch.randn(*s, dtype=torch.bfloat16) * 0.05)(Df, Dm) * (Df ** -0.5)),
    }

def reference(x, w_gate, w_up, w_down):
    g = torch.einsum("bsd,df->bsf", x, w_gate)
    u = torch.einsum("bsd,df->bsf", x, w_up)
    h = _gelu(g) * u
    return torch.einsum("bsf,fd->bsd", h, w_down)
```

```asm
; @launch grid=(224,1,1) block=(256,1,1) lds=4352
.amdgcn_target "amdgcn-amd-amdhsa--gfx950"
.text
.globl standalone__glu_gated_geglu__decode_kernel
.p2align 8
.type standalone__glu_gated_geglu__decode_kernel,@function
standalone__glu_gated_geglu__decode_kernel:
    s_load_dwordx2 s[12:13], s[0:1], 8
    s_load_dwordx2 s[16:17], s[0:1], 16
    s_load_dwordx2 s[8:9], s[0:1], 0
    s_load_dwordx2 s[64:65], s[0:1], 40
    s_load_dwordx2 s[28:29], s[0:1], 48
    s_load_dwordx2 s[20:21], s[0:1], 24
    s_load_dwordx2 s[24:25], s[0:1], 32
    s_cmp_ge_u32 s2, 224
    s_cbranch_scc1 L_done
    s_and_b32 s4, s2, 7
    s_lshr_b32 s5, s2, 3
    s_mov_b32 s14, 7340032
    s_mov_b32 s15, 0x00020000
    s_mov_b32 s18, 7340032
    s_mov_b32 s19, 0x00020000
    s_movk_i32 s10, 2048
    s_mov_b32 s11, 0x00020000
    s_mul_i32 s40, s4, 917504
    v_lshrrev_b32 v3, 4, v0
    v_and_b32 v155, 15, v0
    v_lshlrev_b32 v154, 4, v155
    v_lshl_add_u32 v2, v3, 14, v154
    v_mov_b32 v136, 0x7fff0000
    s_lshl_b32 s6, s5, 8
    v_mul_u32_u24 v1, 57344, v3
    v_add3_u32 v1, v1, v154, s6
    v_lshlrev_b32 v3, 4, v3
    s_lshl_b32 s6, s4, 8
    s_add_u32 s41, s40, 7168
    s_add_u32 s42, s40, 14336
    s_add_u32 s43, s40, 21504
    s_add_u32 s44, s40, 28672
    s_add_u32 s45, s40, 35840
    s_add_u32 s46, s40, 43008
    s_add_u32 s47, s40, 50176
    s_waitcnt lgkmcnt(0)
    buffer_load_dwordx4 v[4:7], v3, s[8:11], s6 offen
    buffer_load_dwordx4 v[48:51], v1, s[12:15], s40 offen nt
    buffer_load_dwordx4 v[80:83], v1, s[16:19], s40 offen nt
    s_load_dword s7, s[28:29], 0
    buffer_load_dwordx4 v[52:55], v1, s[12:15], s41 offen nt
    buffer_load_dwordx4 v[84:87], v1, s[16:19], s41 offen nt
    s_getreg_b32 s34, hwreg(HW_REG_XCC_ID)
    s_movk_i32 s66, 256
    s_mov_b32 s67, 0x00020000
    buffer_load_dwordx4 v[56:59], v1, s[12:15], s42 offen nt
    buffer_load_dwordx4 v[88:91], v1, s[16:19], s42 offen nt
    s_and_b32 s34, s34, 15
    s_or_b32 s34, s34, 0x80
    s_lshl_b32 s35, s4, 5
    buffer_load_dwordx4 v[60:63], v1, s[12:15], s43 offen nt
    buffer_load_dwordx4 v[92:95], v1, s[16:19], s43 offen nt
    v_mov_b32 v144, s34
    s_sub_u32 s32, s5, 0
    s_lshl_b32 s33, s32, 2
    buffer_load_dwordx4 v[64:67], v1, s[12:15], s44 offen nt
    buffer_load_dwordx4 v[96:99], v1, s[16:19], s44 offen nt
    s_cmp_lt_u32 s32, 8
    s_cselect_b32 s33, s33, 0x1000
    s_add_u32 s33, s33, s35
    v_lshlrev_b32 v145, 8, v0
    buffer_load_dwordx4 v[68:71], v1, s[12:15], s45 offen nt
    buffer_load_dwordx4 v[100:103], v1, s[16:19], s45 offen nt
    buffer_load_dwordx4 v[72:75], v1, s[12:15], s46 offen nt
    buffer_load_dwordx4 v[104:107], v1, s[16:19], s46 offen nt
    buffer_load_dwordx4 v[76:79], v1, s[12:15], s47 offen nt
    buffer_load_dwordx4 v[108:111], v1, s[16:19], s47 offen nt
    buffer_store_dword v144, v145, s[64:67], s33 offen sc1
    v_readfirstlane_b32 s3, v0
    s_mov_b32 s30, 786432
    s_mov_b32 s31, 0x00020000
    s_movk_i32 s26, 2048
    s_mov_b32 s27, 0x00020000
    s_mov_b32 s22, 7340032
    s_mov_b32 s23, 0x00020000
    buffer_load_dword v148, v145, s[24:27], 0 offen
    s_lshl_b32 s48, s5, 18
    s_add_u32 s48, s48, s6
    s_add_u32 s49, s48, 4096
    s_add_u32 s50, s48, 8192
    s_add_u32 s51, s48, 12288
    s_lshr_b32 s3, s3, 6
    v_and_b32 v16, 1, v0
    v_cmp_eq_u32 vcc, 1, v16
    v_mov_b32 v17, 0x0c0c0100
    v_mov_b32 v18, 0x01000c0c
    v_mov_b32 v19, 0x0c0c0302
    v_mov_b32 v20, 0x03020c0c
    v_cndmask_b32 v17, v17, v18, vcc
    v_cndmask_b32 v19, v19, v20, vcc
    v_mov_b32 v21, 0xffff
    v_mov_b32 v22, 0xffff0000
    v_cndmask_b32 v21, v21, v22, vcc
    v_bfe_u32 v16, v0, 1, 2
    v_mov_b32 v18, 0x0c0c0c0c
    v_cmp_eq_u32 vcc, 0, v16
    v_mul_u32_u24 v156, 0x110, v155
    v_bfe_u32 v129, v0, 2, 2
    v_cndmask_b32 v8, v18, v17, vcc
    v_cndmask_b32 v12, v18, v19, vcc
    v_cndmask_b32 v124, 0, v21, vcc
    v_cmp_eq_u32 vcc, 1, v16
    v_and_b32 v130, 3, v0
    v_lshlrev_b32 v130, 4, v130
    v_cndmask_b32 v9, v18, v17, vcc
    v_cndmask_b32 v13, v18, v19, vcc
    v_cndmask_b32 v125, 0, v21, vcc
    v_cmp_eq_u32 vcc, 2, v16
    v_bfe_u32 v131, v0, 4, 2
    v_lshl_add_u32 v130, v131, 6, v130
    v_cndmask_b32 v10, v18, v17, vcc
    v_cndmask_b32 v14, v18, v19, vcc
    v_cndmask_b32 v126, 0, v21, vcc
    v_cmp_eq_u32 vcc, 3, v16
    v_add_u32 v156, v156, v3
    s_nop 0
    v_cndmask_b32 v11, v18, v17, vcc
    v_cndmask_b32 v15, v18, v19, vcc
    v_cndmask_b32 v127, 0, v21, vcc
    v_lshlrev_b32 v157, 4, v0
    v_add_u32 v157, v157, v3
    v_bfe_u32 v153, v0, 4, 2
    v_lshl_add_u32 v152, v129, 2, v130
    v_lshl_add_u32 v151, v129, 10, v130
    s_lshl_b32 s6, s3, 8
    s_lshl_b32 s36, s2, 10
    s_add_u32 s36, s36, s6
    s_add_u32 s36, s36, 4096
    s_lshl_b32 s37, s5, 13
    s_add_u32 s37, s37, s6
    s_add_u32 s37, s37, 4096
    s_add_u32 s38, s37, 4096
    v_and_b32 v150, 7, v0
    v_lshlrev_b32 v149, 2, v150
    v_lshlrev_b32 v150, 3, v150
    v_lshl_add_u32 v150, v153, 1, v150
    s_lshl_b32 s6, s3, 6
    v_add_u32 v150, s6, v150
    v_lshrrev_b32 v158, 1, v155
    v_mul_u32_u24 v158, 7168, v158
    v_and_b32 v159, 1, v0
    v_lshl_add_u32 v158, v159, 5, v158
    v_and_b32 v159, 16, v0
    v_add_u32 v158, v158, v159
    s_mul_i32 s52, s4, 57344
    s_add_u32 s52, s52, 270336
    s_mul_i32 s90, s32, 7168
    s_add_u32 s90, s90, s52
    s_lshl_b32 s91, s3, 4
    s_add_u32 s90, s90, s91
    s_lshl_b32 s91, s5, 8
    s_add_u32 s52, s52, s91
    s_add_u32 s52, s52, s6
    v_mov_b32 v159, 63
    s_mov_b32 s56, 0xc0135761
    s_mov_b32 s58, 0x3d372713
    s_mov_b32 s60, 0xffff0000
    s_mov_b32 s55, 4294967232
    s_mov_b32 s62, 0x80000
    s_mov_b32 s92, 0x100000
    s_mov_b32 s54, 4294966272
    v_mov_b32 v143, 1023
    v_lshlrev_b32 v146, 6, v0
    v_cmp_gt_u32 vcc, 0x70, v0
    s_cmp_lt_u32 s32, 8
    s_cselect_b32 s63, s90, 0x7fff0000
    v_cndmask_b32 v146, v136, v146, vcc
    s_waitcnt lgkmcnt(0)
    s_add_u32 s61, s7, 1
    s_and_b32 s7, s61, 63
    s_and_b32 s53, s61, 1023
    v_mov_b32 v137, s7
    v_cmp_eq_u32 vcc, s4, v129
    s_sub_u32 s6, s4, 4
    s_nop 0
    v_cndmask_b32 v132, v151, v136, vcc
    v_cndmask_b32 v134, v137, 0, vcc
    v_cmp_eq_u32 vcc, s6, v129
    s_nop 1
    v_cndmask_b32 v133, v151, v136, vcc
    v_cndmask_b32 v135, v137, 0, vcc
    s_waitcnt vmcnt(17)
    v_perm_b32 v16, v4, v4, v8
    v_perm_b32 v17, v4, v4, v9
    v_perm_b32 v18, v4, v4, v10
    v_perm_b32 v19, v4, v4, v11
    v_perm_b32 v20, v4, v4, v12
    v_perm_b32 v21, v4, v4, v13
    v_perm_b32 v22, v4, v4, v14
    v_perm_b32 v23, v4, v4, v15
    v_perm_b32 v24, v5, v5, v8
    v_perm_b32 v25, v5, v5, v9
    v_perm_b32 v26, v5, v5, v10
    v_perm_b32 v27, v5, v5, v11
    v_perm_b32 v28, v5, v5, v12
    v_perm_b32 v29, v5, v5, v13
    v_perm_b32 v30, v5, v5, v14
    v_perm_b32 v31, v5, v5, v15
    v_perm_b32 v32, v6, v6, v8
    v_perm_b32 v33, v6, v6, v9
    v_perm_b32 v34, v6, v6, v10
    v_perm_b32 v35, v6, v6, v11
    v_perm_b32 v36, v6, v6, v12
    v_perm_b32 v37, v6, v6, v13
    v_perm_b32 v38, v6, v6, v14
    v_perm_b32 v39, v6, v6, v15
    v_perm_b32 v40, v7, v7, v8
    v_perm_b32 v41, v7, v7, v9
    v_perm_b32 v42, v7, v7, v10
    v_perm_b32 v43, v7, v7, v11
    v_perm_b32 v44, v7, v7, v12
    v_perm_b32 v45, v7, v7, v13
    v_perm_b32 v46, v7, v7, v14
    v_perm_b32 v47, v7, v7, v15
    s_waitcnt vmcnt(15)
    v_mfma_f32_16x16x32_bf16 v[112:115], v[16:19], v[48:51], 0
    v_mfma_f32_16x16x32_bf16 v[116:119], v[16:19], v[80:83], 0
    s_waitcnt vmcnt(13)
    v_mfma_f32_16x16x32_bf16 v[112:115], v[20:23], v[52:55], v[112:115]
    v_mfma_f32_16x16x32_bf16 v[116:119], v[20:23], v[84:87], v[116:119]
    s_waitcnt vmcnt(11)
    v_mfma_f32_16x16x32_bf16 v[112:115], v[24:27], v[56:59], v[112:115]
    v_mfma_f32_16x16x32_bf16 v[116:119], v[24:27], v[88:91], v[116:119]
    s_waitcnt vmcnt(9)
    v_mfma_f32_16x16x32_bf16 v[112:115], v[28:31], v[60:63], v[112:115]
    v_mfma_f32_16x16x32_bf16 v[116:119], v[28:31], v[92:95], v[116:119]
    s_waitcnt vmcnt(7)
    v_mfma_f32_16x16x32_bf16 v[112:115], v[32:35], v[64:67], v[112:115]
    v_mfma_f32_16x16x32_bf16 v[116:119], v[32:35], v[96:99], v[116:119]
    s_waitcnt vmcnt(5)
    v_mfma_f32_16x16x32_bf16 v[112:115], v[36:39], v[68:71], v[112:115]
    v_mfma_f32_16x16x32_bf16 v[116:119], v[36:39], v[100:103], v[116:119]
    s_waitcnt vmcnt(3)
    v_mfma_f32_16x16x32_bf16 v[112:115], v[40:43], v[72:75], v[112:115]
    v_mfma_f32_16x16x32_bf16 v[116:119], v[40:43], v[104:107], v[116:119]
    s_waitcnt vmcnt(1)
    v_mfma_f32_16x16x32_bf16 v[112:115], v[44:47], v[76:79], v[112:115]
    v_mfma_f32_16x16x32_bf16 v[116:119], v[44:47], v[108:111], v[116:119]
    buffer_load_dwordx4 v[160:163], v2, s[20:23], s48 offen offset:0 nt
    buffer_load_dwordx4 v[164:167], v2, s[20:23], s48 offen offset:2048 nt
    buffer_load_dwordx4 v[168:171], v2, s[20:23], s49 offen offset:0 nt
    buffer_load_dwordx4 v[172:175], v2, s[20:23], s49 offen offset:2048 nt
    s_mov_b32 exec_hi, 0
    s_nop 2
    ds_write_b128 v156, v[112:115]
    s_mov_b64 exec, -1
    s_mov_b32 exec_lo, 0
    ds_write_b128 v156, v[116:119]
    s_mov_b64 exec, -1
    s_waitcnt lgkmcnt(0)
    s_barrier
    ds_read_b128 v[112:115], v157
    s_waitcnt lgkmcnt(0)
    v_add_f32_dpp v116, v112, v112 row_ror:8 row_mask:0xf bank_mask:0x3
    v_add_f32_dpp v117, v113, v113 row_ror:8 row_mask:0xf bank_mask:0x3
    v_add_f32_dpp v116, v114, v114 row_ror:8 row_mask:0xf bank_mask:0xc
    v_add_f32_dpp v117, v115, v115 row_ror:8 row_mask:0xf bank_mask:0xc
    s_nop 0
    v_add_f32_dpp v112, v116, v116 row_ror:12 row_mask:0xf bank_mask:0x5
    v_add_f32_dpp v112, v117, v117 row_ror:4 row_mask:0xf bank_mask:0xa
    v_add_u32 v112, 32, v112
    v_bfi_b32 v113, v159, s7, v112
    buffer_store_dword v113, v152, s[28:31], s36 offen sc1
    s_barrier
    buffer_load_dwordx4 v[176:179], v2, s[20:23], s50 offen offset:0 nt
    buffer_load_dwordx4 v[180:183], v2, s[20:23], s50 offen offset:2048 nt
    buffer_load_dwordx4 v[184:187], v2, s[20:23], s51 offen offset:0 nt
    buffer_load_dwordx4 v[188:191], v2, s[20:23], s51 offen offset:2048 nt
    buffer_load_dword v147, v146, s[28:31], s63 offen sc1
    v_and_b32 v112, s55, v112
    buffer_load_dword v88, v149, s[64:67], s35 offen sc1
    buffer_load_dwordx4 v[96:99], v132, s[28:31], s37 offen sc1
    buffer_load_dwordx4 v[100:103], v133, s[28:31], s38 offen sc1
    s_waitcnt vmcnt(3)
L_p1:
    buffer_load_dword v89, v149, s[64:67], s35 offen sc1
    buffer_load_dwordx4 v[104:107], v132, s[28:31], s37 offen sc1
    buffer_load_dwordx4 v[108:111], v133, s[28:31], s38 offen sc1
    s_waitcnt vmcnt(5)
    v_cmp_ne_u32 s[68:69], s34, v88
    s_waitcnt vmcnt(4)
    v_bitop3_b32 v92, v96, v97, v134 bitop3:0x7e
    v_bitop3_b32 v93, v98, v99, v134 bitop3:0x7e
    v_and_b32 v80, s55, v96
    v_and_b32 v81, s55, v97
    v_and_b32 v82, s55, v98
    v_and_b32 v83, s55, v99
    s_waitcnt vmcnt(3)
    v_bitop3_b32 v94, v100, v101, v135 bitop3:0x7e
    v_bitop3_b32 v95, v102, v103, v135 bitop3:0x7e
    v_or3_b32 v92, v92, v93, v94
    v_bitop3_b32 v92, v92, v95, v159 bitop3:0xa8
    v_cmp_ne_u32 vcc, 0, v92
    v_and_b32 v84, s55, v100
    v_and_b32 v85, s55, v101
    v_and_b32 v86, s55, v102
    v_and_b32 v87, s55, v103
    v_pk_add_f32 v[80:81], v[80:81], v[84:85]
    v_pk_add_f32 v[82:83], v[82:83], v[86:87]
    s_cbranch_vccz L_p1ok
    buffer_load_dword v88, v149, s[64:67], s35 offen sc1
    buffer_load_dwordx4 v[96:99], v132, s[28:31], s37 offen sc1
    buffer_load_dwordx4 v[100:103], v133, s[28:31], s38 offen sc1
    s_waitcnt vmcnt(5)
    v_cmp_ne_u32 s[68:69], s34, v89
    s_waitcnt vmcnt(4)
    v_bitop3_b32 v92, v104, v105, v134 bitop3:0x7e
    v_bitop3_b32 v93, v106, v107, v134 bitop3:0x7e
    v_and_b32 v80, s55, v104
    v_and_b32 v81, s55, v105
    v_and_b32 v82, s55, v106
    v_and_b32 v83, s55, v107
    s_waitcnt vmcnt(3)
    v_bitop3_b32 v94, v108, v109, v135 bitop3:0x7e
    v_bitop3_b32 v95, v110, v111, v135 bitop3:0x7e
    v_or3_b32 v92, v92, v93, v94
    v_bitop3_b32 v92, v92, v95, v159 bitop3:0xa8
    v_cmp_ne_u32 vcc, 0, v92
    v_and_b32 v84, s55, v108
    v_and_b32 v85, s55, v109
    v_and_b32 v86, s55, v110
    v_and_b32 v87, s55, v111
    v_pk_add_f32 v[80:81], v[80:81], v[84:85]
    v_pk_add_f32 v[82:83], v[82:83], v[86:87]
    s_cbranch_vccz L_p1ok
    s_sub_u32 s62, s62, 1
    s_cbranch_scc0 L_p1
L_p1ok:
    s_nop 0
    v_add_f32_dpp v84, v80, v80 row_ror:8 row_mask:0xf bank_mask:0x3
    v_add_f32_dpp v85, v81, v81 row_ror:8 row_mask:0xf bank_mask:0x3
    v_add_f32_dpp v84, v82, v82 row_ror:8 row_mask:0xf bank_mask:0xc
    v_add_f32_dpp v85, v83, v83 row_ror:8 row_mask:0xf bank_mask:0xc
    s_nop 0
    v_add_f32_dpp v80, v84, v84 row_ror:12 row_mask:0xf bank_mask:0x5
    v_add_f32_dpp v80, v85, v85 row_ror:4 row_mask:0xf bank_mask:0xa
    v_add_f32 v80, v80, v112
    v_cvt_pk_bf16_f32 v80, v80, v80
    v_and_b32 v80, s60, v80
    v_mul_f32 v82, v80, v80
    v_mul_f32 v83, s56, v80
    v_mov_b32_dpp v81, v80 quad_perm:[2,3,0,1] row_mask:0xf bank_mask:0xf
    v_fma_f32 v82, v82, s58, 1.0
    v_mul_f32 v82, v82, v83
    v_exp_f32 v82, v82
    s_nop 0
    v_add_f32 v82, 1.0, v82
    v_rcp_f32 v82, v82
    s_nop 0
    v_mul_f32 v82, v82, v80
    v_cvt_pk_bf16_f32 v82, v82, v82
    v_and_b32 v82, s60, v82
    v_mul_f32 v82, v82, v81
    v_cvt_pk_bf16_f32 v85, v82, v82
    s_nop 1
    v_and_b32_dpp v16, v85, v124 row_newbcast:0 row_mask:0xf bank_mask:0xf
    v_and_b32_dpp v17, v85, v125 row_newbcast:0 row_mask:0xf bank_mask:0xf
    v_and_b32_dpp v18, v85, v126 row_newbcast:0 row_mask:0xf bank_mask:0xf
    v_and_b32_dpp v19, v85, v127 row_newbcast:0 row_mask:0xf bank_mask:0xf
    v_and_b32_dpp v20, v85, v124 row_newbcast:4 row_mask:0xf bank_mask:0xf
    v_and_b32_dpp v21, v85, v125 row_newbcast:4 row_mask:0xf bank_mask:0xf
    v_and_b32_dpp v22, v85, v126 row_newbcast:4 row_mask:0xf bank_mask:0xf
    v_and_b32_dpp v23, v85, v127 row_newbcast:4 row_mask:0xf bank_mask:0xf
    v_mfma_f32_16x16x32_bf16 v[112:115], v[16:19], v[160:163], 0
    v_and_b32_dpp v24, v85, v124 row_newbcast:8 row_mask:0xf bank_mask:0xf
    v_and_b32_dpp v25, v85, v125 row_newbcast:8 row_mask:0xf bank_mask:0xf
    v_and_b32_dpp v26, v85, v126 row_newbcast:8 row_mask:0xf bank_mask:0xf
    v_and_b32_dpp v27, v85, v127 row_newbcast:8 row_mask:0xf bank_mask:0xf
    v_mfma_f32_16x16x32_bf16 v[112:115], v[20:23], v[164:167], v[112:115]
    v_and_b32_dpp v28, v85, v124 row_newbcast:12 row_mask:0xf bank_mask:0xf
    v_and_b32_dpp v29, v85, v125 row_newbcast:12 row_mask:0xf bank_mask:0xf
    v_and_b32_dpp v30, v85, v126 row_newbcast:12 row_mask:0xf bank_mask:0xf
    v_and_b32_dpp v31, v85, v127 row_newbcast:12 row_mask:0xf bank_mask:0xf
    v_mfma_f32_16x16x32_bf16 v[112:115], v[24:27], v[168:171], v[112:115]
    v_and_b32_dpp v32, v85, v124 row_newbcast:1 row_mask:0xf bank_mask:0xf
    v_and_b32_dpp v33, v85, v125 row_newbcast:1 row_mask:0xf bank_mask:0xf
    v_and_b32_dpp v34, v85, v126 row_newbcast:1 row_mask:0xf bank_mask:0xf
    v_and_b32_dpp v35, v85, v127 row_newbcast:1 row_mask:0xf bank_mask:0xf
    v_mfma_f32_16x16x32_bf16 v[112:115], v[28:31], v[172:175], v[112:115]
    v_and_b32_dpp v36, v85, v124 row_newbcast:5 row_mask:0xf bank_mask:0xf
    v_and_b32_dpp v37, v85, v125 row_newbcast:5 row_mask:0xf bank_mask:0xf
    v_and_b32_dpp v38, v85, v126 row_newbcast:5 row_mask:0xf bank_mask:0xf
    v_and_b32_dpp v39, v85, v127 row_newbcast:5 row_mask:0xf bank_mask:0xf
    v_mfma_f32_16x16x32_bf16 v[112:115], v[32:35], v[176:179], v[112:115]
    v_and_b32_dpp v40, v85, v124 row_newbcast:9 row_mask:0xf bank_mask:0xf
    v_and_b32_dpp v41, v85, v125 row_newbcast:9 row_mask:0xf bank_mask:0xf
    v_and_b32_dpp v42, v85, v126 row_newbcast:9 row_mask:0xf bank_mask:0xf
    v_and_b32_dpp v43, v85, v127 row_newbcast:9 row_mask:0xf bank_mask:0xf
    v_mfma_f32_16x16x32_bf16 v[112:115], v[36:39], v[180:183], v[112:115]
    v_and_b32_dpp v44, v85, v124 row_newbcast:13 row_mask:0xf bank_mask:0xf
    v_and_b32_dpp v45, v85, v125 row_newbcast:13 row_mask:0xf bank_mask:0xf
    v_and_b32_dpp v46, v85, v126 row_newbcast:13 row_mask:0xf bank_mask:0xf
    v_and_b32_dpp v47, v85, v127 row_newbcast:13 row_mask:0xf bank_mask:0xf
    v_mfma_f32_16x16x32_bf16 v[112:115], v[40:43], v[184:187], v[112:115]
    s_nop 0
    v_mfma_f32_16x16x32_bf16 v[112:115], v[44:47], v[188:191], v[112:115]
    s_cmp_eq_u64 s[68:69], 0
    v_and_b32 v84, 63, v0
    v_lshlrev_b32 v80, 6, v84
    v_cmp_gt_u32 vcc, 48, v84
    v_mov_b32 v82, s53
    v_lshlrev_b32 v83, 1, v153
    v_cndmask_b32 v81, v136, v80, vcc
    v_cndmask_b32 v82, 0, v82, vcc
    v_add_u32 v112, 512, v112
    v_add_u32 v113, 512, v113
    v_add_u32 v114, 512, v114
    v_add_u32 v115, 512, v115
    v_bfi_b32 v112, v143, s53, v112
    v_bfi_b32 v113, v143, s53, v113
    v_bfi_b32 v114, v143, s53, v114
    v_bfi_b32 v115, v143, s53, v115
    s_cbranch_scc0 L_dslow
    buffer_store_dwordx4 v[112:115], v158, s[28:31], s52 offen
L_dst:
    s_cmp_ge_u32 s32, 8
    s_cbranch_scc1 L_xdone
    s_add_u32 s91, s90, 4096
L_p2:
    buffer_load_dwordx4 v[48:51], v80, s[28:31], s90 offen sc1
    buffer_load_dwordx4 v[52:55], v81, s[28:31], s91 offen sc1
    s_lshl_b32 s46, s4, 8
    s_lshl_b32 s6, s32, 5
    s_add_u32 s46, s46, s6
    s_lshl_b32 s6, s3, 3
    s_add_u32 s46, s46, s6
    s_waitcnt vmcnt(1)
    v_bitop3_b32 v56, v48, v49, s53 bitop3:0x7e
    v_bitop3_b32 v57, v50, v51, s53 bitop3:0x7e
    v_and_b32 v48, s54, v48
    v_and_b32 v49, s54, v49
    v_and_b32 v50, s54, v50
    v_and_b32 v51, s54, v51
    s_waitcnt vmcnt(0)
    v_bitop3_b32 v58, v52, v53, v82 bitop3:0x7e
    v_bitop3_b32 v59, v54, v55, v82 bitop3:0x7e
    v_or3_b32 v56, v56, v57, v58
    v_bitop3_b32 v56, v56, v59, v143 bitop3:0xa8
    v_cmp_ne_u32 vcc, 0, v56
    v_and_b32 v52, s54, v52
    v_and_b32 v53, s54, v53
    v_and_b32 v54, s54, v54
    v_and_b32 v55, s54, v55
    v_pk_add_f32 v[48:49], v[48:49], v[52:53]
    v_pk_add_f32 v[50:51], v[50:51], v[54:55]
    s_cbranch_vccz L_p2ok
    s_sub_u32 s92, s92, 1
    s_cbranch_scc0 L_p2
L_p2ok:
    s_nop 0
    v_permlane32_swap_b32 v48, v50
    v_permlane32_swap_b32 v49, v51
    s_nop 0
    v_pk_add_f32 v[48:49], v[48:49], v[50:51]
    s_nop 1
    v_permlane16_swap_b32 v48, v49
    s_nop 0
    v_add_f32 v48, v48, v49
    s_nop 1
    v_add_f32_dpp v48, v48, v48 row_ror:8 row_mask:0xf bank_mask:0xf
    s_nop 1
    v_add_f32_dpp v48, v48, v48 row_ror:4 row_mask:0xf bank_mask:0xf
    s_nop 1
    v_add_f32_dpp v48, v48, v48 row_ror:2 row_mask:0xf bank_mask:0xf
    s_nop 1
    v_add_f32_dpp v48, v48, v48 row_ror:1 row_mask:0xf bank_mask:0xf
    v_cvt_pk_bf16_f32 v48, v48, v48
    s_mov_b32 exec_lo, 0x00010001
    s_mov_b32 exec_hi, 0x00010001
    buffer_store_short v48, v83, s[24:27], s46 offen
    s_cmp_lg_u32 s46, 0
    s_cbranch_scc1 L_xdone
    s_mov_b64 exec, 1
    v_mov_b32 v49, s61
    buffer_store_dword v49, v83, s[28:31], 0 offen
L_xdone:
L_done:
    s_endpgm
L_dslow:
    buffer_store_dwordx4 v[112:115], v158, s[28:31], s52 offen sc1
    s_branch L_dst
.section .rodata,"a"
.p2align 6
.amdhsa_kernel standalone__glu_gated_geglu__decode_kernel
  .amdhsa_next_free_vgpr 192
  .amdhsa_next_free_sgpr 96
  .amdhsa_accum_offset 192
  .amdhsa_group_segment_fixed_size 0
  .amdhsa_kernarg_size 56
  .amdhsa_user_sgpr_count 2
  .amdhsa_user_sgpr_kernarg_segment_ptr 1
  .amdhsa_system_sgpr_workgroup_id_x 1
  .amdhsa_float_denorm_mode_32 3
.end_amdhsa_kernel
```
